```python
import torch

def _softmax(x, axis=-1):
    return torch.softmax(x, dim=axis)

def _gelu(x):
    return torch.nn.functional.gelu(x, approximate='tanh')

def _silu(x):
    return torch.nn.functional.silu(x)

def _sigmoid(x):
    return torch.sigmoid(x)

def _layernorm(x, axis=-1, eps=1e-05):
    m = x.mean(dim=axis, keepdim=True)
    v = x.var(dim=axis, keepdim=True, unbiased=False)
    return (x - m) / torch.sqrt(v + eps)

def _scatter_add(tgt, idx, src, axis=0):
    return tgt.clone().index_add_(axis, idx, src)

def _segment_sum(src, seg, n):
    out = torch.zeros((n,) + src.shape[1:], dtype=src.dtype)
    return out.index_add_(0, seg, src)

def _pad(x, pw):
    flat = tuple((v for pair in reversed(pw) for v in pair))
    return torch.nn.functional.pad(x, flat)
kernel_name = 'standalone__tree_speculative_verify_tree_attention_over_candidate_token_tree__decode'

def setup_inputs():

    _w = lambda a: (lambda t: t.to(torch.bfloat16) if t.is_floating_point() else t)(torch.as_tensor(a))
    B, Hq, Hkv, T, C, D = (1, 32, 32, 1, 8192, 128)
    tree_mask = torch.zeros((B, T, T), dtype=float)
    for b in range(B):
        parent = torch.zeros(T, dtype=torch.int64)
        for i in range(1, T):
            parent[i] = int(torch.randint(0, i, (1,)).item())
        for i in range(T):
            j = i
            tree_mask[b, i, j] = 1.0
            while j > 0:
                j = parent[j]
                tree_mask[b, i, j] = 1.0
    return {'q': _w((lambda *s: torch.randn(*s, dtype=torch.bfloat16) * 0.8)(B, Hq, T, D)), 'k_cache': _w((lambda *s: torch.randn(*s, dtype=torch.bfloat16) * 0.8)(B, Hkv, C, D)), 'v_cache': _w((lambda *s: torch.randn(*s, dtype=torch.bfloat16) * 0.05)(B, Hkv, C, D)), 'k_tree': _w((lambda *s: torch.randn(*s, dtype=torch.bfloat16) * 0.8)(B, Hkv, T, D)), 'v_tree': _w((lambda *s: torch.randn(*s, dtype=torch.bfloat16) * 0.05)(B, Hkv, T, D)), 'tree_mask': _w(tree_mask)}

def reference(q, k_cache, v_cache, k_tree, v_tree, tree_mask):
    B, Hq, T, D = q.shape
    Hkv, C = (k_cache.shape[1], k_cache.shape[2])
    rep = Hq // Hkv
    kc = (lambda x, n, axis: torch.repeat_interleave(x, n, dim=axis))(k_cache, rep, axis=1)
    vc = (lambda x, n, axis: torch.repeat_interleave(x, n, dim=axis))(v_cache, rep, axis=1)
    kt = (lambda x, n, axis: torch.repeat_interleave(x, n, dim=axis))(k_tree, rep, axis=1)
    vt = (lambda x, n, axis: torch.repeat_interleave(x, n, dim=axis))(v_tree, rep, axis=1)
    k = torch.concatenate([kc, kt], axis=2)
    v = torch.concatenate([vc, vt], axis=2)
    scale = D ** (-0.5)
    scores = torch.einsum('bhqd,bhkd->bhqk', q, k) * scale
    ctx_mask = torch.ones((B, 1, T, C), dtype=scores.dtype)
    tm = tree_mask[:, None, :, :].clone()
    full_mask = torch.concatenate([ctx_mask, tm], axis=-1)
    scores = scores + (1.0 - full_mask) * -1000000000.0
    p = _softmax(scores, axis=-1)
    return torch.einsum('bhqk,bhkd->bhqd', p, v)
```

```asm
; @launch grid=(256,1,1) block=(320,1,1) lds=2304
.amdgcn_target "amdgcn-amd-amdhsa--gfx950"
.text
.globl standalone__tree_speculative_verify_tree_attention_over_candidate_token_tree__decode_kernel
.p2align 8
.type standalone__tree_speculative_verify_tree_attention_over_candidate_token_tree__decode_kernel,@function
standalone__tree_speculative_verify_tree_attention_over_candidate_token_tree__decode_kernel:
    s_load_dwordx16 s[4:19], s[0:1], 0
    s_load_dwordx2 s[20:21], s[0:1], 64
    s_cmp_ge_u32 s2, 256
    s_cbranch_scc1 L_end
    v_and_b32 v1, 63, v0
    v_lshrrev_b32 v2, 6, v0
    v_and_b32 v3, 15, v0
    v_readfirstlane_b32 s22, v2
    v_lshlrev_b32 v4, 4, v1
    s_lshr_b32 s3, s2, 3
    s_lshl_b32 s36, s3, 8
    v_lshlrev_b32 v50, 4, v3
    v_add_u32 v50, s36, v50
    s_cmp_eq_u32 s22, 4
    s_cbranch_scc1 L_helper
    s_lshl_b32 s35, s2, 18
    s_lshl_b32 s33, s22, 10
    s_add_u32 s35, s35, s33
    s_mov_b32 s39, 0
    s_mov_b32 s61, 0
    s_add_u32 s32, s35, s39
    s_add_u32 s39, s39, 65536
    s_and_b32 s39, s39, 0x3ffff
    s_add_u32 s33, s35, s39
    s_lshr_b32 s38, s2, 3
    s_and_b32 s38, s38, 15
    s_lshl_b32 s38, s38, 12
    v_add_u32 v64, s38, v4
    v_add_u32 v65, 4096, v64
    v_and_b32 v65, 0xffff, v65
    v_add_u32 v66, 8192, v64
    v_and_b32 v66, 0xffff, v66
    v_add_u32 v67, 12288, v64
    v_and_b32 v67, 0xffff, v67
    v_add_u32 v68, 16384, v64
    v_and_b32 v68, 0xffff, v68
    v_add_u32 v69, 20480, v64
    v_and_b32 v69, 0xffff, v69
    s_mov_b32 s26, 0x4000000
    s_mov_b32 s27, 0x00020000
    s_mov_b32 s30, 0x4000000
    s_mov_b32 s31, 0x00020000
    s_mov_b32 s46, 0x4000000
    s_mov_b32 s47, 0x00020000
    s_waitcnt lgkmcnt(0)
    s_mov_b32 s44, s6
    s_mov_b32 s45, s7
    s_mov_b32 s24, s6
    s_mov_b32 s25, s7
    s_mov_b32 s28, s8
    s_mov_b32 s29, s9
    buffer_load_dwordx4 v[80:83], v64, s[24:27], s32 offen nt
    global_load_dwordx4 v[8:11], v50, s[4:5]
    buffer_load_dwordx4 v[84:87], v65, s[24:27], s32 offen nt
    buffer_load_dwordx4 v[88:91], v66, s[24:27], s32 offen nt
    buffer_load_dwordx4 v[92:95], v67, s[24:27], s32 offen nt
    buffer_load_dwordx4 v[96:99], v68, s[24:27], s32 offen nt
    buffer_load_dwordx4 v[100:103], v69, s[24:27], s32 offen nt
    v_add_u32 v70, 24576, v64
    v_and_b32 v70, 0xffff, v70
    v_add_u32 v71, 28672, v64
    v_and_b32 v71, 0xffff, v71
    v_add_u32 v72, 32768, v64
    v_and_b32 v72, 0xffff, v72
    v_add_u32 v73, 36864, v64
    v_and_b32 v73, 0xffff, v73
    v_add_u32 v74, 40960, v64
    v_and_b32 v74, 0xffff, v74
    v_add_u32 v75, 45056, v64
    v_and_b32 v75, 0xffff, v75
    v_add_u32 v76, 49152, v64
    v_and_b32 v76, 0xffff, v76
    v_add_u32 v77, 53248, v64
    v_and_b32 v77, 0xffff, v77
    v_add_u32 v78, 57344, v64
    v_and_b32 v78, 0xffff, v78
    v_add_u32 v79, 61440, v64
    v_and_b32 v79, 0xffff, v79
    v_and_b32 v50, 1, v3
    v_lshlrev_b32 v50, 4, v50
    v_mov_b32 v51, 0xffff
    v_lshlrev_b32 v50, v50, v51
    v_lshrrev_b32 v51, 1, v3
    v_cmp_eq_u32 vcc, 0, v51
    s_nop 1
    v_cndmask_b32 v28, 0, v50, vcc
    v_cmp_eq_u32 vcc, 1, v51
    s_nop 1
    v_cndmask_b32 v29, 0, v50, vcc
    v_cmp_eq_u32 vcc, 2, v51
    s_nop 1
    v_cndmask_b32 v30, 0, v50, vcc
    v_cmp_eq_u32 vcc, 3, v51
    s_nop 1
    v_cndmask_b32 v31, 0, v50, vcc
    s_mov_b32 s40, 0xcccccccc
    s_mov_b32 s41, 0xcccccccc
    s_mov_b32 s42, 0xaaaaaaaa
    s_mov_b32 s43, 0xaaaaaaaa
    v_mov_b32 v49, 0xff800000
    v_mov_b32 v47, 0
    v_mov_b32 v40, 0
    v_mov_b32 v41, 0
    v_mov_b32 v42, 0
    v_mov_b32 v43, 0
    v_lshrrev_b32 v56, 4, v1
    v_lshlrev_b32 v56, 4, v56
    v_lshl_add_u32 v56, v3, 5, v56
    s_lshl_b32 s38, s22, 9
    v_add_u32 v56, s38, v56
    s_lshl_b32 s38, s22, 3
    s_add_u32 s38, s38, 2048
    v_mov_b32 v57, s38
    s_waitcnt vmcnt(5)
    s_mov_b32 s34, 4
L_loop:
    s_waitcnt vmcnt(5)
    v_dot2_f32_bf16 v12, v80, v8, 0
    v_dot2_f32_bf16 v12, v81, v9, v12
    v_dot2_f32_bf16 v12, v82, v10, v12
    v_dot2_f32_bf16 v12, v83, v11, v12
    buffer_load_dwordx4 v[104:107], v70, s[24:27], s32 offen nt
    s_waitcnt vmcnt(5)
    v_dot2_f32_bf16 v13, v84, v8, 0
    v_dot2_f32_bf16 v13, v85, v9, v13
    v_dot2_f32_bf16 v13, v86, v10, v13
    v_dot2_f32_bf16 v13, v87, v11, v13
    buffer_load_dwordx4 v[108:111], v71, s[24:27], s32 offen nt
    s_waitcnt vmcnt(5)
    v_dot2_f32_bf16 v14, v88, v8, 0
    v_dot2_f32_bf16 v14, v89, v9, v14
    v_dot2_f32_bf16 v14, v90, v10, v14
    v_dot2_f32_bf16 v14, v91, v11, v14
    buffer_load_dwordx4 v[80:83], v72, s[24:27], s32 offen nt
    s_waitcnt vmcnt(5)
    v_dot2_f32_bf16 v15, v92, v8, 0
    v_dot2_f32_bf16 v15, v93, v9, v15
    v_dot2_f32_bf16 v15, v94, v10, v15
    v_dot2_f32_bf16 v15, v95, v11, v15
    buffer_load_dwordx4 v[84:87], v73, s[24:27], s32 offen nt
    s_waitcnt vmcnt(5)
    v_dot2_f32_bf16 v16, v96, v8, 0
    v_dot2_f32_bf16 v16, v97, v9, v16
    v_dot2_f32_bf16 v16, v98, v10, v16
    v_dot2_f32_bf16 v16, v99, v11, v16
    buffer_load_dwordx4 v[88:91], v74, s[24:27], s32 offen nt
    s_waitcnt vmcnt(5)
    v_dot2_f32_bf16 v17, v100, v8, 0
    v_dot2_f32_bf16 v17, v101, v9, v17
    v_dot2_f32_bf16 v17, v102, v10, v17
    v_dot2_f32_bf16 v17, v103, v11, v17
    buffer_load_dwordx4 v[92:95], v75, s[24:27], s32 offen nt
    s_waitcnt vmcnt(5)
    v_dot2_f32_bf16 v18, v104, v8, 0
    v_dot2_f32_bf16 v18, v105, v9, v18
    v_dot2_f32_bf16 v18, v106, v10, v18
    v_dot2_f32_bf16 v18, v107, v11, v18
    buffer_load_dwordx4 v[96:99], v76, s[24:27], s32 offen nt
    s_waitcnt vmcnt(5)
    v_dot2_f32_bf16 v19, v108, v8, 0
    v_dot2_f32_bf16 v19, v109, v9, v19
    v_dot2_f32_bf16 v19, v110, v10, v19
    v_dot2_f32_bf16 v19, v111, v11, v19
    buffer_load_dwordx4 v[100:103], v77, s[24:27], s32 offen nt
    s_waitcnt vmcnt(5)
    v_dot2_f32_bf16 v20, v80, v8, 0
    v_dot2_f32_bf16 v20, v81, v9, v20
    v_dot2_f32_bf16 v20, v82, v10, v20
    v_dot2_f32_bf16 v20, v83, v11, v20
    buffer_load_dwordx4 v[104:107], v78, s[24:27], s32 offen nt
    s_waitcnt vmcnt(5)
    v_dot2_f32_bf16 v21, v84, v8, 0
    v_dot2_f32_bf16 v21, v85, v9, v21
    v_dot2_f32_bf16 v21, v86, v10, v21
    v_dot2_f32_bf16 v21, v87, v11, v21
    buffer_load_dwordx4 v[108:111], v79, s[24:27], s32 offen nt
    s_waitcnt vmcnt(5)
    v_dot2_f32_bf16 v22, v88, v8, 0
    v_dot2_f32_bf16 v22, v89, v9, v22
    v_dot2_f32_bf16 v22, v90, v10, v22
    v_dot2_f32_bf16 v22, v91, v11, v22
    buffer_load_dwordx4 v[80:83], v64, s[28:31], s32 offen nt
    s_waitcnt vmcnt(5)
    v_dot2_f32_bf16 v23, v92, v8, 0
    v_dot2_f32_bf16 v23, v93, v9, v23
    v_dot2_f32_bf16 v23, v94, v10, v23
    v_dot2_f32_bf16 v23, v95, v11, v23
    buffer_load_dwordx4 v[84:87], v65, s[28:31], s32 offen nt
    s_waitcnt vmcnt(5)
    v_dot2_f32_bf16 v24, v96, v8, 0
    v_dot2_f32_bf16 v24, v97, v9, v24
    v_dot2_f32_bf16 v24, v98, v10, v24
    v_dot2_f32_bf16 v24, v99, v11, v24
    buffer_load_dwordx4 v[88:91], v66, s[28:31], s32 offen nt
    s_waitcnt vmcnt(5)
    v_dot2_f32_bf16 v25, v100, v8, 0
    v_dot2_f32_bf16 v25, v101, v9, v25
    v_dot2_f32_bf16 v25, v102, v10, v25
    v_dot2_f32_bf16 v25, v103, v11, v25
    buffer_load_dwordx4 v[92:95], v67, s[28:31], s32 offen nt
    s_waitcnt vmcnt(5)
    v_dot2_f32_bf16 v26, v104, v8, 0
    v_dot2_f32_bf16 v26, v105, v9, v26
    v_dot2_f32_bf16 v26, v106, v10, v26
    v_dot2_f32_bf16 v26, v107, v11, v26
    buffer_load_dwordx4 v[96:99], v68, s[28:31], s32 offen nt
    s_waitcnt vmcnt(5)
    v_dot2_f32_bf16 v27, v108, v8, 0
    v_dot2_f32_bf16 v27, v109, v9, v27
    v_dot2_f32_bf16 v27, v110, v10, v27
    v_dot2_f32_bf16 v27, v111, v11, v27
    buffer_load_dwordx4 v[100:103], v69, s[28:31], s32 offen nt
    s_nop 1
    v_add_f32_dpp v12, v12, v12 row_ror:8 row_mask:0xf bank_mask:0x3
    v_add_f32_dpp v13, v13, v13 row_ror:8 row_mask:0xf bank_mask:0x3
    v_add_f32_dpp v14, v14, v14 row_ror:8 row_mask:0xf bank_mask:0x3
    v_add_f32_dpp v15, v15, v15 row_ror:8 row_mask:0xf bank_mask:0x3
    v_add_f32_dpp v16, v16, v16 row_ror:8 row_mask:0xf bank_mask:0x3
    v_add_f32_dpp v17, v17, v17 row_ror:8 row_mask:0xf bank_mask:0x3
    v_add_f32_dpp v18, v18, v18 row_ror:8 row_mask:0xf bank_mask:0x3
    v_add_f32_dpp v19, v19, v19 row_ror:8 row_mask:0xf bank_mask:0x3
    v_add_f32_dpp v12, v20, v20 row_ror:8 row_mask:0xf bank_mask:0xc
    v_add_f32_dpp v13, v21, v21 row_ror:8 row_mask:0xf bank_mask:0xc
    v_add_f32_dpp v14, v22, v22 row_ror:8 row_mask:0xf bank_mask:0xc
    v_add_f32_dpp v15, v23, v23 row_ror:8 row_mask:0xf bank_mask:0xc
    v_add_f32_dpp v16, v24, v24 row_ror:8 row_mask:0xf bank_mask:0xc
    v_add_f32_dpp v17, v25, v25 row_ror:8 row_mask:0xf bank_mask:0xc
    v_add_f32_dpp v18, v26, v26 row_ror:8 row_mask:0xf bank_mask:0xc
    v_add_f32_dpp v19, v27, v27 row_ror:8 row_mask:0xf bank_mask:0xc
    s_nop 1
    v_add_f32_dpp v12, v12, v12 row_half_mirror row_mask:0xf bank_mask:0x5
    v_add_f32_dpp v13, v13, v13 row_half_mirror row_mask:0xf bank_mask:0x5
    v_add_f32_dpp v14, v14, v14 row_half_mirror row_mask:0xf bank_mask:0x5
    v_add_f32_dpp v15, v15, v15 row_half_mirror row_mask:0xf bank_mask:0x5
    v_add_f32_dpp v12, v16, v16 row_half_mirror row_mask:0xf bank_mask:0xa
    v_add_f32_dpp v13, v17, v17 row_half_mirror row_mask:0xf bank_mask:0xa
    v_add_f32_dpp v14, v18, v18 row_half_mirror row_mask:0xf bank_mask:0xa
    v_add_f32_dpp v15, v19, v19 row_half_mirror row_mask:0xf bank_mask:0xa
    s_nop 1
    v_add_f32_dpp v12, v12, v12 quad_perm:[2,3,0,1] row_mask:0xf bank_mask:0xf
    v_add_f32_dpp v13, v13, v13 quad_perm:[2,3,0,1] row_mask:0xf bank_mask:0xf
    v_add_f32_dpp v14, v14, v14 quad_perm:[2,3,0,1] row_mask:0xf bank_mask:0xf
    v_add_f32_dpp v15, v15, v15 quad_perm:[2,3,0,1] row_mask:0xf bank_mask:0xf
    v_cndmask_b32 v12, v12, v14, s[40:41]
    v_cndmask_b32 v13, v13, v15, s[40:41]
    s_nop 1
    v_add_f32_dpp v12, v12, v12 quad_perm:[1,0,3,2] row_mask:0xf bank_mask:0xf
    v_add_f32_dpp v13, v13, v13 quad_perm:[1,0,3,2] row_mask:0xf bank_mask:0xf
    v_cndmask_b32 v12, v12, v13, s[42:43]
    v_mul_f32 v44, 0x3e0293ee, v12
    v_max_f32 v45, v44, v49
    s_nop 1
    v_max_f32_dpp v45, v45, v45 row_ror:8 row_mask:0xf bank_mask:0xf
    s_nop 1
    v_max_f32_dpp v45, v45, v45 row_ror:4 row_mask:0xf bank_mask:0xf
    s_nop 1
    v_max_f32_dpp v45, v45, v45 row_ror:2 row_mask:0xf bank_mask:0xf
    s_nop 1
    v_max_f32_dpp v45, v45, v45 row_ror:1 row_mask:0xf bank_mask:0xf
    s_nop 1
    v_mov_b32 v50, v45
    s_nop 1
    v_permlane32_swap_b32 v45, v50
    v_max_f32 v45, v45, v50
    v_mov_b32 v50, v45
    s_nop 1
    v_permlane16_swap_b32 v45, v50
    v_max_f32 v45, v45, v50
    v_sub_f32 v46, v44, v45
    v_sub_f32 v52, v49, v45
    v_exp_f32 v46, v46
    v_exp_f32 v52, v52
    v_mov_b32 v49, v45
    v_cvt_pk_bf16_f32 v48, v46, v46
    v_fma_f32 v47, v47, v52, v46
    v_mul_f32 v40, v52, v40
    v_mul_f32 v41, v52, v41
    v_mul_f32 v42, v52, v42
    v_mul_f32 v43, v52, v43
    v_mov_b32 v58, v47
    s_nop 1
    v_add_f32_dpp v58, v58, v58 row_ror:8 row_mask:0xf bank_mask:0xf
    s_nop 1
    v_add_f32_dpp v58, v58, v58 row_ror:4 row_mask:0xf bank_mask:0xf
    s_nop 1
    v_add_f32_dpp v58, v58, v58 row_ror:2 row_mask:0xf bank_mask:0xf
    s_nop 1
    v_add_f32_dpp v58, v58, v58 row_ror:1 row_mask:0xf bank_mask:0xf
    s_nop 1
    v_mov_b32 v50, v58
    s_nop 1
    v_permlane32_swap_b32 v58, v50
    v_add_f32 v58, v58, v50
    v_mov_b32 v50, v58
    s_nop 1
    v_permlane16_swap_b32 v58, v50
    v_add_f32 v55, v58, v50
    v_mov_b32 v54, v49
    ds_write_b64 v57, v[54:55]
    v_and_b32_dpp v32, v48, v28 row_newbcast:0 row_mask:0xf bank_mask:0xf
    v_and_b32_dpp v33, v48, v29 row_newbcast:0 row_mask:0xf bank_mask:0xf
    v_and_b32_dpp v34, v48, v30 row_newbcast:0 row_mask:0xf bank_mask:0xf
    v_and_b32_dpp v35, v48, v31 row_newbcast:0 row_mask:0xf bank_mask:0xf
    s_waitcnt vmcnt(5)
    s_nop 0
    v_mfma_f32_16x16x32_bf16 v[40:43], v[32:35], v[80:83], v[40:43]
    buffer_load_dwordx4 v[104:107], v70, s[28:31], s32 offen nt
    v_and_b32_dpp v36, v48, v28 row_newbcast:1 row_mask:0xf bank_mask:0xf
    v_and_b32_dpp v37, v48, v29 row_newbcast:1 row_mask:0xf bank_mask:0xf
    v_and_b32_dpp v38, v48, v30 row_newbcast:1 row_mask:0xf bank_mask:0xf
    v_and_b32_dpp v39, v48, v31 row_newbcast:1 row_mask:0xf bank_mask:0xf
    s_waitcnt vmcnt(5)
    s_nop 0
    v_mfma_f32_16x16x32_bf16 v[40:43], v[36:39], v[84:87], v[40:43]
    buffer_load_dwordx4 v[108:111], v71, s[28:31], s32 offen nt
    v_and_b32_dpp v32, v48, v28 row_newbcast:2 row_mask:0xf bank_mask:0xf
    v_and_b32_dpp v33, v48, v29 row_newbcast:2 row_mask:0xf bank_mask:0xf
    v_and_b32_dpp v34, v48, v30 row_newbcast:2 row_mask:0xf bank_mask:0xf
    v_and_b32_dpp v35, v48, v31 row_newbcast:2 row_mask:0xf bank_mask:0xf
    s_waitcnt vmcnt(5)
    s_nop 0
    v_mfma_f32_16x16x32_bf16 v[40:43], v[32:35], v[88:91], v[40:43]
    buffer_load_dwordx4 v[80:83], v72, s[28:31], s32 offen nt
    v_and_b32_dpp v36, v48, v28 row_newbcast:3 row_mask:0xf bank_mask:0xf
    v_and_b32_dpp v37, v48, v29 row_newbcast:3 row_mask:0xf bank_mask:0xf
    v_and_b32_dpp v38, v48, v30 row_newbcast:3 row_mask:0xf bank_mask:0xf
    v_and_b32_dpp v39, v48, v31 row_newbcast:3 row_mask:0xf bank_mask:0xf
    s_waitcnt vmcnt(5)
    s_nop 0
    v_mfma_f32_16x16x32_bf16 v[40:43], v[36:39], v[92:95], v[40:43]
    buffer_load_dwordx4 v[84:87], v73, s[28:31], s32 offen nt
    v_and_b32_dpp v32, v48, v28 row_newbcast:4 row_mask:0xf bank_mask:0xf
    v_and_b32_dpp v33, v48, v29 row_newbcast:4 row_mask:0xf bank_mask:0xf
    v_and_b32_dpp v34, v48, v30 row_newbcast:4 row_mask:0xf bank_mask:0xf
    v_and_b32_dpp v35, v48, v31 row_newbcast:4 row_mask:0xf bank_mask:0xf
    s_waitcnt vmcnt(5)
    s_nop 0
    v_mfma_f32_16x16x32_bf16 v[40:43], v[32:35], v[96:99], v[40:43]
    buffer_load_dwordx4 v[88:91], v74, s[28:31], s32 offen nt
    v_and_b32_dpp v36, v48, v28 row_newbcast:5 row_mask:0xf bank_mask:0xf
    v_and_b32_dpp v37, v48, v29 row_newbcast:5 row_mask:0xf bank_mask:0xf
    v_and_b32_dpp v38, v48, v30 row_newbcast:5 row_mask:0xf bank_mask:0xf
    v_and_b32_dpp v39, v48, v31 row_newbcast:5 row_mask:0xf bank_mask:0xf
    s_waitcnt vmcnt(5)
    s_nop 0
    v_mfma_f32_16x16x32_bf16 v[40:43], v[36:39], v[100:103], v[40:43]
    buffer_load_dwordx4 v[92:95], v75, s[28:31], s32 offen nt
    v_and_b32_dpp v32, v48, v28 row_newbcast:6 row_mask:0xf bank_mask:0xf
    v_and_b32_dpp v33, v48, v29 row_newbcast:6 row_mask:0xf bank_mask:0xf
    v_and_b32_dpp v34, v48, v30 row_newbcast:6 row_mask:0xf bank_mask:0xf
    v_and_b32_dpp v35, v48, v31 row_newbcast:6 row_mask:0xf bank_mask:0xf
    s_waitcnt vmcnt(5)
    s_nop 0
    v_mfma_f32_16x16x32_bf16 v[40:43], v[32:35], v[104:107], v[40:43]
    buffer_load_dwordx4 v[96:99], v76, s[28:31], s32 offen nt
    v_and_b32_dpp v36, v48, v28 row_newbcast:7 row_mask:0xf bank_mask:0xf
    v_and_b32_dpp v37, v48, v29 row_newbcast:7 row_mask:0xf bank_mask:0xf
    v_and_b32_dpp v38, v48, v30 row_newbcast:7 row_mask:0xf bank_mask:0xf
    v_and_b32_dpp v39, v48, v31 row_newbcast:7 row_mask:0xf bank_mask:0xf
    s_waitcnt vmcnt(5)
    s_nop 0
    v_mfma_f32_16x16x32_bf16 v[40:43], v[36:39], v[108:111], v[40:43]
    buffer_load_dwordx4 v[100:103], v77, s[28:31], s32 offen nt
    v_and_b32_dpp v32, v48, v28 row_newbcast:8 row_mask:0xf bank_mask:0xf
    v_and_b32_dpp v33, v48, v29 row_newbcast:8 row_mask:0xf bank_mask:0xf
    v_and_b32_dpp v34, v48, v30 row_newbcast:8 row_mask:0xf bank_mask:0xf
    v_and_b32_dpp v35, v48, v31 row_newbcast:8 row_mask:0xf bank_mask:0xf
    s_waitcnt vmcnt(5)
    s_nop 0
    v_mfma_f32_16x16x32_bf16 v[40:43], v[32:35], v[80:83], v[40:43]
    buffer_load_dwordx4 v[104:107], v78, s[28:31], s32 offen nt
    v_and_b32_dpp v36, v48, v28 row_newbcast:9 row_mask:0xf bank_mask:0xf
    v_and_b32_dpp v37, v48, v29 row_newbcast:9 row_mask:0xf bank_mask:0xf
    v_and_b32_dpp v38, v48, v30 row_newbcast:9 row_mask:0xf bank_mask:0xf
    v_and_b32_dpp v39, v48, v31 row_newbcast:9 row_mask:0xf bank_mask:0xf
    s_waitcnt vmcnt(5)
    s_nop 0
    v_mfma_f32_16x16x32_bf16 v[40:43], v[36:39], v[84:87], v[40:43]
    buffer_load_dwordx4 v[108:111], v79, s[28:31], s32 offen nt
    v_and_b32_dpp v32, v48, v28 row_newbcast:10 row_mask:0xf bank_mask:0xf
    v_and_b32_dpp v33, v48, v29 row_newbcast:10 row_mask:0xf bank_mask:0xf
    v_and_b32_dpp v34, v48, v30 row_newbcast:10 row_mask:0xf bank_mask:0xf
    v_and_b32_dpp v35, v48, v31 row_newbcast:10 row_mask:0xf bank_mask:0xf
    s_waitcnt vmcnt(5)
    s_nop 0
    v_mfma_f32_16x16x32_bf16 v[40:43], v[32:35], v[88:91], v[40:43]
    buffer_load_dwordx4 v[80:83], v64, s[44:47], s33 offen nt
    v_and_b32_dpp v36, v48, v28 row_newbcast:11 row_mask:0xf bank_mask:0xf
    v_and_b32_dpp v37, v48, v29 row_newbcast:11 row_mask:0xf bank_mask:0xf
    v_and_b32_dpp v38, v48, v30 row_newbcast:11 row_mask:0xf bank_mask:0xf
    v_and_b32_dpp v39, v48, v31 row_newbcast:11 row_mask:0xf bank_mask:0xf
    s_waitcnt vmcnt(5)
    s_nop 0
    v_mfma_f32_16x16x32_bf16 v[40:43], v[36:39], v[92:95], v[40:43]
    buffer_load_dwordx4 v[84:87], v65, s[44:47], s33 offen nt
    v_and_b32_dpp v32, v48, v28 row_newbcast:12 row_mask:0xf bank_mask:0xf
    v_and_b32_dpp v33, v48, v29 row_newbcast:12 row_mask:0xf bank_mask:0xf
    v_and_b32_dpp v34, v48, v30 row_newbcast:12 row_mask:0xf bank_mask:0xf
    v_and_b32_dpp v35, v48, v31 row_newbcast:12 row_mask:0xf bank_mask:0xf
    s_waitcnt vmcnt(5)
    s_nop 0
    v_mfma_f32_16x16x32_bf16 v[40:43], v[32:35], v[96:99], v[40:43]
    buffer_load_dwordx4 v[88:91], v66, s[44:47], s33 offen nt
    v_and_b32_dpp v36, v48, v28 row_newbcast:13 row_mask:0xf bank_mask:0xf
    v_and_b32_dpp v37, v48, v29 row_newbcast:13 row_mask:0xf bank_mask:0xf
    v_and_b32_dpp v38, v48, v30 row_newbcast:13 row_mask:0xf bank_mask:0xf
    v_and_b32_dpp v39, v48, v31 row_newbcast:13 row_mask:0xf bank_mask:0xf
    s_waitcnt vmcnt(5)
    s_nop 0
    v_mfma_f32_16x16x32_bf16 v[40:43], v[36:39], v[100:103], v[40:43]
    buffer_load_dwordx4 v[92:95], v67, s[44:47], s33 offen nt
    v_and_b32_dpp v32, v48, v28 row_newbcast:14 row_mask:0xf bank_mask:0xf
    v_and_b32_dpp v33, v48, v29 row_newbcast:14 row_mask:0xf bank_mask:0xf
    v_and_b32_dpp v34, v48, v30 row_newbcast:14 row_mask:0xf bank_mask:0xf
    v_and_b32_dpp v35, v48, v31 row_newbcast:14 row_mask:0xf bank_mask:0xf
    s_waitcnt vmcnt(5)
    s_nop 0
    v_mfma_f32_16x16x32_bf16 v[40:43], v[32:35], v[104:107], v[40:43]
    buffer_load_dwordx4 v[96:99], v68, s[44:47], s33 offen nt
    v_and_b32_dpp v36, v48, v28 row_newbcast:15 row_mask:0xf bank_mask:0xf
    v_and_b32_dpp v37, v48, v29 row_newbcast:15 row_mask:0xf bank_mask:0xf
    v_and_b32_dpp v38, v48, v30 row_newbcast:15 row_mask:0xf bank_mask:0xf
    v_and_b32_dpp v39, v48, v31 row_newbcast:15 row_mask:0xf bank_mask:0xf
    s_waitcnt vmcnt(5)
    s_nop 0
    v_mfma_f32_16x16x32_bf16 v[40:43], v[36:39], v[108:111], v[40:43]
    buffer_load_dwordx4 v[100:103], v69, s[44:47], s33 offen nt
    s_cmp_lg_u32 s34, 4
    s_cbranch_scc1 L_nomid
    s_barrier
L_nomid:
    s_mov_b32 s32, s33
    s_add_u32 s39, s39, 65536
    s_and_b32 s39, s39, 0x3ffff
    s_xor_b32 s37, s39, s61
    s_add_u32 s33, s35, s37
    s_sub_u32 s34, s34, 1
    s_cmp_eq_u32 s34, 1
    s_cselect_b32 s46, 0, s46
    s_cselect_b32 s33, s32, s33
    s_cmp_lg_u32 s34, 0
    s_cbranch_scc1 L_loop
    s_mov_b32 exec_hi, 0
    s_nop 7
    ds_write_b128 v56, v[40:43]
    s_waitcnt lgkmcnt(0)
    s_barrier
    s_endpgm
L_helper:
    s_memrealtime s[44:45]
    s_and_b32 s37, s2, 7
    s_lshl_b32 s39, s3, 2
    v_mov_b32 v6, s39
    v_lshlrev_b32 v5, 2, v1
    v_add_u32 v7, s36, v5
    v_lshlrev_b32 v5, 3, v1
    v_mov_b32 v0, 0
    v_mov_b32 v2, 2048
    s_lshl_b32 s38, s3, 13
    s_cmp_eq_u32 s37, 0
    s_cselect_b32 s48, 1, 0
    s_lshl_b32 s48, s48, 10
    s_add_u32 s48, s48, s38
    s_cmp_eq_u32 s37, 1
    s_cselect_b32 s49, 2, 1
    s_lshl_b32 s49, s49, 10
    s_add_u32 s49, s49, s38
    s_cmp_eq_u32 s37, 2
    s_cselect_b32 s50, 3, 2
    s_lshl_b32 s50, s50, 10
    s_add_u32 s50, s50, s38
    s_cmp_eq_u32 s37, 3
    s_cselect_b32 s51, 4, 3
    s_lshl_b32 s51, s51, 10
    s_add_u32 s51, s51, s38
    s_cmp_eq_u32 s37, 4
    s_cselect_b32 s52, 5, 4
    s_lshl_b32 s52, s52, 10
    s_add_u32 s52, s52, s38
    s_cmp_eq_u32 s37, 5
    s_cselect_b32 s53, 6, 5
    s_lshl_b32 s53, s53, 10
    s_add_u32 s53, s53, s38
    s_cmp_eq_u32 s37, 6
    s_cselect_b32 s54, 7, 6
    s_lshl_b32 s54, s54, 10
    s_add_u32 s54, s54, s38
    s_cmp_eq_u32 s37, 7
    s_cselect_b32 s55, 0, 7
    s_lshl_b32 s55, s55, 10
    s_add_u32 s55, s55, s38
    s_lshl_b32 s62, s37, 10
    s_add_u32 s62, s62, s38
    s_lshl_b32 s63, s37, 2
    s_mov_b32 s26, 0x40000
    s_mov_b32 s27, 0x00020000
    s_waitcnt lgkmcnt(0)
    s_mov_b32 s24, s20
    s_mov_b32 s25, s21
    s_or_b32 s44, s44, 1
    v_mov_b32 v8, s44
    v_mov_b32 v9, 0
    s_cmp_lg_u32 s37, 0
    s_cbranch_scc1 L_notree
    s_mov_b64 exec, 1
    global_atomic_cmpswap v10, v6, v[8:9], s[18:19] sc0
    s_mov_b64 exec, -1
    global_load_dwordx4 v[12:15], v50, s[4:5]
    global_load_dwordx4 v[16:19], v50, s[10:11]
    global_load_dword v20, v7, s[12:13]
    global_load_ushort v21, v0, s[14:15]
    s_waitcnt vmcnt(0)
    v_dot2_f32_bf16 v60, v16, v12, 0
    v_dot2_f32_bf16 v60, v17, v13, v60
    v_dot2_f32_bf16 v60, v18, v14, v60
    v_dot2_f32_bf16 v60, v19, v15, v60
    v_lshlrev_b32 v21, 16, v21
    v_sub_f32 v21, 1.0, v21
    v_mul_f32 v21, 0xce6e6b28, v21
    s_nop 1
    v_add_f32_dpp v60, v60, v60 row_ror:8 row_mask:0xf bank_mask:0xf
    s_nop 1
    v_add_f32_dpp v60, v60, v60 row_ror:4 row_mask:0xf bank_mask:0xf
    s_nop 1
    v_add_f32_dpp v60, v60, v60 row_ror:2 row_mask:0xf bank_mask:0xf
    s_nop 1
    v_add_f32_dpp v60, v60, v60 row_ror:1 row_mask:0xf bank_mask:0xf
    s_nop 1
    v_mov_b32 v22, 0x3db504f3
    v_fma_f32 v60, v60, v22, v21
    v_mul_f32 v60, 0x3fb8aa3b, v60
    v_mov_b32 v61, 1.0
    v_lshlrev_b32 v62, 16, v20
    v_and_b32 v63, 0xffff0000, v20
    s_barrier
    s_branch L_treedone
L_notree:
    v_mov_b32 v60, 0xff800000
    v_mov_b32 v61, 0
    v_mov_b32 v62, 0
    v_mov_b32 v63, 0
    s_barrier
    global_load_dword v10, v6, s[18:19] sc1
    s_waitcnt vmcnt(0)
    v_readfirstlane_b32 s45, v10
    s_nop 3
    s_cmp_lg_u32 s45, 0
    s_cbranch_scc1 L_treedone
    s_mov_b64 exec, 1
    global_atomic_cmpswap v10, v6, v[8:9], s[18:19] sc0
    s_mov_b64 exec, -1
L_treedone:
    s_waitcnt vmcnt(0)
    v_readfirstlane_b32 s45, v10
    s_nop 3
    s_cmp_eq_u32 s45, 0
    s_cselect_b32 s46, s44, s45
    v_mov_b32 v27, s46
    s_mov_b32 s60, 0
    s_barrier
L_tail:
    buffer_load_dwordx4 v[28:31], v4, s[24:27], s48 offen sc1
    buffer_load_dwordx4 v[32:35], v4, s[24:27], s49 offen sc1
    buffer_load_dwordx4 v[36:39], v4, s[24:27], s50 offen sc1
    buffer_load_dwordx4 v[40:43], v4, s[24:27], s51 offen sc1
    buffer_load_dwordx4 v[44:47], v4, s[24:27], s52 offen sc1
    buffer_load_dwordx4 v[48:51], v4, s[24:27], s53 offen sc1
    buffer_load_dwordx4 v[52:55], v4, s[24:27], s54 offen sc1
    buffer_load_dwordx4 v[56:59], v4, s[24:27], s55 offen sc1
    ds_read_b128 v[8:11], v2
    ds_read_b128 v[12:15], v2 offset:16
    ds_read_b64 v[16:17], v5 offset:0
    ds_read_b64 v[18:19], v5 offset:512
    ds_read_b64 v[20:21], v5 offset:1024
    ds_read_b64 v[22:23], v5 offset:1536
    s_waitcnt lgkmcnt(4)
    v_max3_f32 v64, v8, v10, v60
    v_max3_f32 v64, v64, v12, v14
    v_sub_f32 v8, v8, v64
    v_sub_f32 v10, v10, v64
    v_sub_f32 v12, v12, v64
    v_sub_f32 v14, v14, v64
    v_sub_f32 v65, v60, v64
    v_exp_f32 v8, v8
    v_exp_f32 v10, v10
    v_exp_f32 v12, v12
    v_exp_f32 v14, v14
    v_exp_f32 v65, v65
    v_mul_f32 v66, v8, v9
    v_fmac_f32 v66, v10, v11
    v_fmac_f32 v66, v12, v13
    v_fmac_f32 v66, v14, v15
    v_fmac_f32 v66, v65, v61
    v_mul_f32 v24, v65, v62
    v_mul_f32 v25, v65, v63
    v_rcp_f32 v67, v66
    v_log_f32 v26, v66
    s_waitcnt lgkmcnt(0)
    v_fmac_f32 v24, v8, v16
    v_fmac_f32 v25, v8, v17
    v_fmac_f32 v24, v10, v18
    v_fmac_f32 v25, v10, v19
    v_fmac_f32 v24, v12, v20
    v_fmac_f32 v25, v12, v21
    v_fmac_f32 v24, v14, v22
    v_fmac_f32 v25, v14, v23
    v_add_f32 v26, v26, v64
    v_mul_f32 v24, v24, v67
    v_mul_f32 v25, v25, v67
    buffer_store_dwordx4 v[24:27], v4, s[24:27], s62 offen sc1
    s_waitcnt vmcnt(1)
    s_set_gpr_idx_on s63, gpr_idx(DST)
    s_nop 0
    v_mov_b32 v28, v24
    v_mov_b32 v29, v25
    v_mov_b32 v30, v26
    v_mov_b32 v31, v27
    s_nop 0
    s_set_gpr_idx_off
    v_cmp_eq_u32 s[56:57], s46, v31
    v_cmp_eq_u32 vcc, s46, v35
    s_and_b64 s[56:57], s[56:57], vcc
    v_cmp_eq_u32 vcc, s46, v39
    s_and_b64 s[56:57], s[56:57], vcc
    v_cmp_eq_u32 vcc, s46, v43
    s_and_b64 s[56:57], s[56:57], vcc
    v_cmp_eq_u32 vcc, s46, v47
    s_and_b64 s[56:57], s[56:57], vcc
    v_cmp_eq_u32 vcc, s46, v51
    s_and_b64 s[56:57], s[56:57], vcc
    v_cmp_eq_u32 vcc, s46, v55
    s_and_b64 s[56:57], s[56:57], vcc
    v_cmp_eq_u32 vcc, s46, v59
    s_and_b64 s[56:57], s[56:57], vcc
    s_cmp_eq_u64 s[56:57], -1
    s_cbranch_scc1 L_final
    s_waitcnt vmcnt(0)
    buffer_load_dwordx4 v[28:31], v4, s[24:27], s48 offen sc1
    buffer_load_dwordx4 v[32:35], v4, s[24:27], s49 offen sc1
    buffer_load_dwordx4 v[36:39], v4, s[24:27], s50 offen sc1
    buffer_load_dwordx4 v[40:43], v4, s[24:27], s51 offen sc1
    buffer_load_dwordx4 v[44:47], v4, s[24:27], s52 offen sc1
    buffer_load_dwordx4 v[48:51], v4, s[24:27], s53 offen sc1
    buffer_load_dwordx4 v[52:55], v4, s[24:27], s54 offen sc1
    buffer_load_dwordx4 v[56:59], v4, s[24:27], s55 offen sc1
    s_waitcnt vmcnt(0)
    s_set_gpr_idx_on s63, gpr_idx(DST)
    s_nop 0
    v_mov_b32 v28, v24
    v_mov_b32 v29, v25
    v_mov_b32 v30, v26
    v_mov_b32 v31, v27
    s_nop 0
    s_set_gpr_idx_off
    v_cmp_eq_u32 s[56:57], s46, v31
    v_cmp_eq_u32 vcc, s46, v35
    s_and_b64 s[56:57], s[56:57], vcc
    v_cmp_eq_u32 vcc, s46, v39
    s_and_b64 s[56:57], s[56:57], vcc
    v_cmp_eq_u32 vcc, s46, v43
    s_and_b64 s[56:57], s[56:57], vcc
    v_cmp_eq_u32 vcc, s46, v47
    s_and_b64 s[56:57], s[56:57], vcc
    v_cmp_eq_u32 vcc, s46, v51
    s_and_b64 s[56:57], s[56:57], vcc
    v_cmp_eq_u32 vcc, s46, v55
    s_and_b64 s[56:57], s[56:57], vcc
    v_cmp_eq_u32 vcc, s46, v59
    s_and_b64 s[56:57], s[56:57], vcc
    s_cmp_eq_u64 s[56:57], -1
    s_cbranch_scc1 L_final
    s_endpgm
L_final:
    v_max3_f32 v8, v30, v34, v38
    v_max3_f32 v8, v8, v42, v46
    v_max3_f32 v8, v8, v50, v54
    v_max_f32 v8, v8, v58
    v_sub_f32 v30, v30, v8
    v_sub_f32 v34, v34, v8
    v_sub_f32 v38, v38, v8
    v_sub_f32 v42, v42, v8
    v_sub_f32 v46, v46, v8
    v_sub_f32 v50, v50, v8
    v_sub_f32 v54, v54, v8
    v_sub_f32 v58, v58, v8
    v_exp_f32 v30, v30
    v_exp_f32 v34, v34
    v_exp_f32 v38, v38
    v_exp_f32 v42, v42
    v_exp_f32 v46, v46
    v_exp_f32 v50, v50
    v_exp_f32 v54, v54
    v_exp_f32 v58, v58
    s_nop 0
    v_mul_f32 v9, v30, v28
    v_mul_f32 v10, v30, v29
    v_add_f32 v11, v30, v34
    v_fmac_f32 v9, v34, v32
    v_fmac_f32 v10, v34, v33
    v_fmac_f32 v9, v38, v36
    v_fmac_f32 v10, v38, v37
    v_add_f32 v11, v11, v38
    v_fmac_f32 v9, v42, v40
    v_fmac_f32 v10, v42, v41
    v_add_f32 v11, v11, v42
    v_fmac_f32 v9, v46, v44
    v_fmac_f32 v10, v46, v45
    v_add_f32 v11, v11, v46
    v_fmac_f32 v9, v50, v48
    v_fmac_f32 v10, v50, v49
    v_add_f32 v11, v11, v50
    v_fmac_f32 v9, v54, v52
    v_fmac_f32 v10, v54, v53
    v_add_f32 v11, v11, v54
    v_fmac_f32 v9, v58, v56
    v_fmac_f32 v10, v58, v57
    v_add_f32 v11, v11, v58
    v_rcp_f32 v11, v11
    s_nop 0
    v_mul_f32 v9, v9, v11
    v_mul_f32 v10, v10, v11
    v_cvt_pk_bf16_f32 v9, v9, v10
    global_store_dword v7, v9, s[16:17]
L_dump:
L_end:
    s_endpgm
.section .rodata,"a"
.p2align 6
.amdhsa_kernel standalone__tree_speculative_verify_tree_attention_over_candidate_token_tree__decode_kernel
  .amdhsa_next_free_vgpr 112
  .amdhsa_next_free_sgpr 88
  .amdhsa_accum_offset 112
  .amdhsa_group_segment_fixed_size 0
  .amdhsa_kernarg_size 72
  .amdhsa_user_sgpr_count 2
  .amdhsa_user_sgpr_kernarg_segment_ptr 1
  .amdhsa_system_sgpr_workgroup_id_x 1
.end_amdhsa_kernel
```
